```python
import torch

def _softmax(x, axis=-1):
    return torch.softmax(x, dim=axis)
def _gelu(x):
    return torch.nn.functional.gelu(x, approximate="tanh")
def _silu(x):
    return torch.nn.functional.silu(x)
def _sigmoid(x):
    return torch.sigmoid(x)
def _layernorm(x, axis=-1, eps=1e-5):
    m = x.mean(dim=axis, keepdim=True)
    v = x.var(dim=axis, keepdim=True, unbiased=False)
    return (x - m) / torch.sqrt(v + eps)
def _scatter_add(tgt, idx, src, axis=0):
    return tgt.clone().index_add_(axis, idx, src)
def _segment_sum(src, seg, n):
    out = torch.zeros((n,) + src.shape[1:], dtype=src.dtype)
    return out.index_add_(0, seg, src)
def _pad(x, pw):
    flat = tuple(v for pair in reversed(pw) for v in pair)
    return torch.nn.functional.pad(x, flat)

kernel_name = 'standalone__instancenorm__sampling'

def setup_inputs():

    _w = (lambda a: (lambda t: t.to(torch.bfloat16) if t.is_floating_point() else t)(torch.as_tensor(a)))
    B, C, H, W = 32, 512, 16, 32
    return {
        "x": _w(abs((lambda *s: torch.randn(*s, dtype=torch.bfloat16) * 0.05)(B, C, H, W))),
        "g": _w((lambda *s: torch.randn(*s, dtype=torch.bfloat16) * 0.05)(C) + 1.0),
        "b": _w((lambda *s: torch.randn(*s, dtype=torch.bfloat16) * 0.4)(C)),
    }

def reference(x, g, b):
    mu = x.mean(axis=(-2, -1), keepdims=True)
    var = ((x - mu) ** 2).mean(axis=(-2, -1), keepdims=True)
    xhat = (x - mu) / torch.sqrt(var + 1e-5)
    return xhat * g.reshape(1, -1, 1, 1) + b.reshape(1, -1, 1, 1)
```

```asm
; @launch grid=(256,1,1) block=(512,1,1) lds=0
.amdgcn_target "amdgcn-amd-amdhsa--gfx950"
.text
.globl standalone__instancenorm__sampling_kernel
.p2align 12
.p2align 8
.type standalone__instancenorm__sampling_kernel,@function
standalone__instancenorm__sampling_kernel:
    s_load_dwordx8 s[4:11], s[0:1], 0
    s_cmpk_ge_u32 s2, 256
    s_cbranch_scc1 L_done
    s_lshl_b32 s3, s2, 5
    v_lshrrev_b32 v1, 4, v0
    v_add_u32 v1, s3, v1
    v_and_b32 v2, 15, v0
    v_lshlrev_b32 v2, 4, v2
    v_lshl_add_u32 v2, v1, 10, v2
    v_and_b32 v1, 0x1ff, v1
    v_lshlrev_b32 v1, 1, v1
    v_add_u32 v82, 0x800000, v2
    v_mov_b32 v6, 0xffff0000
    s_mov_b32 s12, 0x0000bf80
    s_mov_b32 s13, 0xbf800000
    s_mov_b32 s14, 0x3f803f80
    s_mov_b32 s15, 0x3b000000
    s_mov_b32 s16, 0x3727c5ac
    v_readfirstlane_b32 s17, v0
    s_nop 0
    s_cmpk_eq_u32 s17, 448
    s_cbranch_scc1 L_touch0
L_back:
    s_cmp_eq_u32 s17, -1
    s_waitcnt lgkmcnt(0)
    global_load_dwordx4 v[8:11], v2, s[4:5] offset:0 nt
    global_load_dwordx4 v[12:15], v2, s[4:5] offset:256 nt
    global_load_dwordx4 v[16:19], v2, s[4:5] offset:512 nt
    global_load_dwordx4 v[20:23], v2, s[4:5] offset:768 nt
    global_load_ushort v4, v1, s[6:7]
    global_load_ushort v5, v1, s[8:9]
    s_barrier
    global_load_dwordx4 v[24:27], v82, s[4:5] offset:0 nt
    global_load_dwordx4 v[28:31], v82, s[4:5] offset:256 nt
    global_load_dwordx4 v[32:35], v82, s[4:5] offset:512 nt
    global_load_dwordx4 v[36:39], v82, s[4:5] offset:768 nt
    s_barrier
    s_waitcnt vmcnt(9)
    v_mov_b32_e64 v73, 0
    v_and_b32_dpp v72, v8, v6 row_newbcast:0 row_mask:0xf bank_mask:0xf
    v_dot2_f32_bf16 v40, v8, s12, v72
    v_dot2_f32_bf16 v41, v8, s13, v72
    v_dot2_f32_bf16 v42, v9, s12, v72
    v_dot2_f32_bf16 v43, v9, s13, v72
    v_dot2_f32_bf16 v44, v10, s12, v72
    v_dot2_f32_bf16 v45, v10, s13, v72
    v_dot2_f32_bf16 v46, v11, s12, v72
    v_dot2_f32_bf16 v47, v11, s13, v72
    v_dot2c_f32_bf16 v73, s14, v8
    v_dot2c_f32_bf16 v73, s14, v9
    v_dot2c_f32_bf16 v73, s14, v10
    v_dot2c_f32_bf16 v73, s14, v11
    v_pk_mul_f32 v[74:75], v[40:41], v[40:41]
    v_pk_fma_f32 v[74:75], v[42:43], v[42:43], v[74:75]
    v_pk_fma_f32 v[74:75], v[44:45], v[44:45], v[74:75]
    v_pk_fma_f32 v[74:75], v[46:47], v[46:47], v[74:75]
    s_waitcnt vmcnt(8)
    v_dot2c_f32_bf16 v73, s14, v12
    v_dot2_f32_bf16 v48, v12, s12, v72
    v_dot2_f32_bf16 v49, v12, s13, v72
    v_dot2_f32_bf16 v50, v13, s12, v72
    v_dot2_f32_bf16 v51, v13, s13, v72
    v_dot2_f32_bf16 v52, v14, s12, v72
    v_dot2_f32_bf16 v53, v14, s13, v72
    v_dot2_f32_bf16 v54, v15, s12, v72
    v_dot2_f32_bf16 v55, v15, s13, v72
    v_dot2c_f32_bf16 v73, s14, v13
    v_dot2c_f32_bf16 v73, s14, v14
    v_pk_fma_f32 v[74:75], v[48:49], v[48:49], v[74:75]
    v_pk_fma_f32 v[74:75], v[50:51], v[50:51], v[74:75]
    v_pk_fma_f32 v[74:75], v[52:53], v[52:53], v[74:75]
    v_pk_fma_f32 v[74:75], v[54:55], v[54:55], v[74:75]
    v_dot2c_f32_bf16 v73, s14, v15
    s_waitcnt vmcnt(7)
    v_dot2c_f32_bf16 v73, s14, v16
    s_nop 0
    v_dot2_f32_bf16 v56, v16, s12, v72
    v_dot2_f32_bf16 v57, v16, s13, v72
    v_dot2_f32_bf16 v58, v17, s12, v72
    v_dot2_f32_bf16 v59, v17, s13, v72
    v_dot2_f32_bf16 v60, v18, s12, v72
    v_dot2_f32_bf16 v61, v18, s13, v72
    v_dot2_f32_bf16 v62, v19, s12, v72
    v_dot2_f32_bf16 v63, v19, s13, v72
    v_dot2c_f32_bf16 v73, s14, v17
    v_dot2c_f32_bf16 v73, s14, v18
    v_pk_fma_f32 v[74:75], v[56:57], v[56:57], v[74:75]
    v_pk_fma_f32 v[74:75], v[58:59], v[58:59], v[74:75]
    v_pk_fma_f32 v[74:75], v[60:61], v[60:61], v[74:75]
    v_pk_fma_f32 v[74:75], v[62:63], v[62:63], v[74:75]
    v_dot2c_f32_bf16 v73, s14, v19
    s_waitcnt vmcnt(6)
    v_dot2c_f32_bf16 v73, s14, v20
    v_dot2c_f32_bf16 v73, s14, v21
    v_dot2c_f32_bf16 v73, s14, v22
    v_dot2c_f32_bf16 v73, s14, v23
    v_dot2_f32_bf16 v64, v20, s12, v72
    v_dot2_f32_bf16 v65, v20, s13, v72
    v_dot2_f32_bf16 v66, v21, s12, v72
    v_add_f32_dpp v73, v73, v73 row_ror:8 row_mask:0xf bank_mask:0xf
    v_dot2_f32_bf16 v67, v21, s13, v72
    v_dot2_f32_bf16 v68, v22, s12, v72
    v_add_f32_dpp v73, v73, v73 row_ror:4 row_mask:0xf bank_mask:0xf
    v_dot2_f32_bf16 v69, v22, s13, v72
    v_dot2_f32_bf16 v70, v23, s12, v72
    v_add_f32_dpp v73, v73, v73 row_ror:2 row_mask:0xf bank_mask:0xf
    v_dot2_f32_bf16 v71, v23, s13, v72
    v_pk_fma_f32 v[74:75], v[64:65], v[64:65], v[74:75]
    v_add_f32_dpp v73, v73, v73 row_ror:1 row_mask:0xf bank_mask:0xf
    v_pk_fma_f32 v[74:75], v[66:67], v[66:67], v[74:75]
    v_pk_fma_f32 v[74:75], v[68:69], v[68:69], v[74:75]
    v_pk_fma_f32 v[74:75], v[70:71], v[70:71], v[74:75]
    v_add_f32 v74, v74, v75
    v_mul_f32 v3, s15, v73
    v_cvt_pk_bf16_f32 v78, 0, v3
    v_add_f32_dpp v74, v74, v74 row_ror:8 row_mask:0xf bank_mask:0xf
    v_sub_f32 v77, v72, v3
    v_sub_f32 v79, v78, v3
    v_add_f32_dpp v74, v74, v74 row_ror:4 row_mask:0xf bank_mask:0xf
    v_mul_f32 v79, v79, v79
    v_sub_f32 v78, v72, v78
    v_add_f32_dpp v74, v74, v74 row_ror:2 row_mask:0xf bank_mask:0xf
    v_fma_f32 v79, -v77, v77, v79
    s_waitcnt vmcnt(4)
    v_lshlrev_b32 v4, 16, v4
    v_lshlrev_b32_e64 v5, 16, v5
    v_add_f32_dpp v74, v74, v74 row_ror:1 row_mask:0xf bank_mask:0xf
    v_fmac_f32 v79, s15, v74
    v_cvt_pk_bf16_f32 v79, 0, v79
    v_add_f32 v79, s16, v79
    v_cvt_pk_bf16_f32 v79, 0, v79
    v_sqrt_f32 v79, v79
    v_mul_f32 v81, v78, v4
    v_cvt_pk_bf16_f32 v79, 0, v79
    v_rcp_f32 v79, v79
    s_nop 0
    v_mul_f32_e64 v80, -v79, v4
    v_fma_f32 v76, v79, v81, v5
    v_pk_fma_f32 v[40:41], v[40:41], v[80:81], v[76:77] op_sel_hi:[1,0,0]
    v_pk_fma_f32 v[42:43], v[42:43], v[80:81], v[76:77] op_sel_hi:[1,0,0]
    v_pk_fma_f32 v[44:45], v[44:45], v[80:81], v[76:77] op_sel_hi:[1,0,0]
    v_pk_fma_f32 v[46:47], v[46:47], v[80:81], v[76:77] op_sel_hi:[1,0,0]
    v_cvt_pk_bf16_f32 v8, v40, v41
    v_cvt_pk_bf16_f32 v9, v42, v43
    v_cvt_pk_bf16_f32 v10, v44, v45
    v_cvt_pk_bf16_f32 v11, v46, v47
    global_store_dwordx4 v2, v[8:11], s[10:11] offset:0 nt
    v_pk_fma_f32 v[48:49], v[48:49], v[80:81], v[76:77] op_sel_hi:[1,0,0]
    v_pk_fma_f32 v[50:51], v[50:51], v[80:81], v[76:77] op_sel_hi:[1,0,0]
    v_pk_fma_f32 v[52:53], v[52:53], v[80:81], v[76:77] op_sel_hi:[1,0,0]
    v_pk_fma_f32 v[54:55], v[54:55], v[80:81], v[76:77] op_sel_hi:[1,0,0]
    v_cvt_pk_bf16_f32 v12, v48, v49
    v_cvt_pk_bf16_f32 v13, v50, v51
    v_cvt_pk_bf16_f32 v14, v52, v53
    v_cvt_pk_bf16_f32 v15, v54, v55
    global_store_dwordx4 v2, v[12:15], s[10:11] offset:256 nt
    v_pk_fma_f32 v[56:57], v[56:57], v[80:81], v[76:77] op_sel_hi:[1,0,0]
    v_pk_fma_f32 v[58:59], v[58:59], v[80:81], v[76:77] op_sel_hi:[1,0,0]
    v_pk_fma_f32 v[60:61], v[60:61], v[80:81], v[76:77] op_sel_hi:[1,0,0]
    v_pk_fma_f32 v[62:63], v[62:63], v[80:81], v[76:77] op_sel_hi:[1,0,0]
    v_cvt_pk_bf16_f32 v16, v56, v57
    v_cvt_pk_bf16_f32 v17, v58, v59
    v_cvt_pk_bf16_f32 v18, v60, v61
L_touch0:
    s_cbranch_scc1 L_touch1
    s_nop 0
    v_cvt_pk_bf16_f32 v19, v62, v63
    global_store_dwordx4 v2, v[16:19], s[10:11] offset:512 nt
    v_pk_fma_f32 v[64:65], v[64:65], v[80:81], v[76:77] op_sel_hi:[1,0,0]
    v_pk_fma_f32 v[66:67], v[66:67], v[80:81], v[76:77] op_sel_hi:[1,0,0]
    v_pk_fma_f32 v[68:69], v[68:69], v[80:81], v[76:77] op_sel_hi:[1,0,0]
    v_pk_fma_f32 v[70:71], v[70:71], v[80:81], v[76:77] op_sel_hi:[1,0,0]
    v_cvt_pk_bf16_f32 v20, v64, v65
L_touch1:
    s_cbranch_scc1 L_touch2
    s_nop 0
    v_cvt_pk_bf16_f32 v21, v66, v67
    v_cvt_pk_bf16_f32 v22, v68, v69
    v_cvt_pk_bf16_f32 v23, v70, v71
    global_store_dwordx4 v2, v[20:23], s[10:11] offset:768 nt
    s_waitcnt vmcnt(7)
    v_mov_b32 v73, 0
    v_and_b32_dpp v72, v24, v6 row_newbcast:0 row_mask:0xf bank_mask:0xf
    v_dot2_f32_bf16 v40, v24, s12, v72
L_touch2:
    s_cbranch_scc1 L_touch3
    s_nop 0
    v_dot2_f32_bf16 v41, v24, s13, v72
    v_dot2_f32_bf16 v42, v25, s12, v72
    v_dot2_f32_bf16 v43, v25, s13, v72
    v_dot2_f32_bf16 v44, v26, s12, v72
    v_dot2_f32_bf16 v45, v26, s13, v72
    v_dot2_f32_bf16 v46, v27, s12, v72
    v_dot2_f32_bf16 v47, v27, s13, v72
L_touch3:
    s_cbranch_scc1 L_back
    s_nop 0
    v_dot2c_f32_bf16 v73, s14, v24
    v_dot2c_f32_bf16 v73, s14, v25
    v_dot2c_f32_bf16 v73, s14, v26
    v_dot2c_f32_bf16 v73, s14, v27
    v_pk_mul_f32 v[74:75], v[40:41], v[40:41]
    v_pk_fma_f32 v[74:75], v[42:43], v[42:43], v[74:75]
    v_pk_fma_f32 v[74:75], v[44:45], v[44:45], v[74:75]
    v_pk_fma_f32 v[74:75], v[46:47], v[46:47], v[74:75]
    s_waitcnt vmcnt(6)
    v_dot2c_f32_bf16 v73, s14, v28
    v_dot2_f32_bf16 v48, v28, s12, v72
    v_dot2_f32_bf16 v49, v28, s13, v72
    v_dot2_f32_bf16 v50, v29, s12, v72
    v_dot2_f32_bf16 v51, v29, s13, v72
    v_dot2_f32_bf16 v52, v30, s12, v72
    v_dot2_f32_bf16 v53, v30, s13, v72
    v_dot2_f32_bf16 v54, v31, s12, v72
    v_dot2_f32_bf16 v55, v31, s13, v72
    v_dot2c_f32_bf16 v73, s14, v29
    v_dot2c_f32_bf16 v73, s14, v30
    v_pk_fma_f32 v[74:75], v[48:49], v[48:49], v[74:75]
    v_pk_fma_f32 v[74:75], v[50:51], v[50:51], v[74:75]
    v_pk_fma_f32 v[74:75], v[52:53], v[52:53], v[74:75]
    v_pk_fma_f32 v[74:75], v[54:55], v[54:55], v[74:75]
    v_dot2c_f32_bf16 v73, s14, v31
    s_waitcnt vmcnt(5)
    v_dot2c_f32_bf16 v73, s14, v32
    s_nop 0
    v_dot2_f32_bf16 v56, v32, s12, v72
    v_dot2_f32_bf16 v57, v32, s13, v72
    v_dot2_f32_bf16 v58, v33, s12, v72
    v_dot2_f32_bf16 v59, v33, s13, v72
    v_dot2_f32_bf16 v60, v34, s12, v72
    v_dot2_f32_bf16 v61, v34, s13, v72
    v_dot2_f32_bf16 v62, v35, s12, v72
    v_dot2_f32_bf16 v63, v35, s13, v72
    v_dot2c_f32_bf16 v73, s14, v33
    v_dot2c_f32_bf16 v73, s14, v34
    v_pk_fma_f32 v[74:75], v[56:57], v[56:57], v[74:75]
    v_pk_fma_f32 v[74:75], v[58:59], v[58:59], v[74:75]
    v_pk_fma_f32 v[74:75], v[60:61], v[60:61], v[74:75]
    v_pk_fma_f32 v[74:75], v[62:63], v[62:63], v[74:75]
    v_dot2c_f32_bf16 v73, s14, v35
    s_waitcnt vmcnt(4)
    v_dot2c_f32_bf16 v73, s14, v36
    v_dot2c_f32_bf16 v73, s14, v37
    v_dot2c_f32_bf16 v73, s14, v38
    v_dot2c_f32_bf16 v73, s14, v39
    v_dot2_f32_bf16 v64, v36, s12, v72
    v_dot2_f32_bf16 v65, v36, s13, v72
    v_dot2_f32_bf16 v66, v37, s12, v72
    v_add_f32_dpp v73, v73, v73 row_ror:8 row_mask:0xf bank_mask:0xf
    v_dot2_f32_bf16 v67, v37, s13, v72
    v_dot2_f32_bf16 v68, v38, s12, v72
    v_add_f32_dpp v73, v73, v73 row_ror:4 row_mask:0xf bank_mask:0xf
    v_dot2_f32_bf16 v69, v38, s13, v72
    v_dot2_f32_bf16 v70, v39, s12, v72
    v_add_f32_dpp v73, v73, v73 row_ror:2 row_mask:0xf bank_mask:0xf
    v_dot2_f32_bf16 v71, v39, s13, v72
    v_pk_fma_f32 v[74:75], v[64:65], v[64:65], v[74:75]
    v_add_f32_dpp v73, v73, v73 row_ror:1 row_mask:0xf bank_mask:0xf
    v_pk_fma_f32 v[74:75], v[66:67], v[66:67], v[74:75]
    v_pk_fma_f32 v[74:75], v[68:69], v[68:69], v[74:75]
    v_pk_fma_f32 v[74:75], v[70:71], v[70:71], v[74:75]
    v_add_f32 v74, v74, v75
    v_mul_f32 v3, s15, v73
    v_cvt_pk_bf16_f32 v78, 0, v3
    v_add_f32_dpp v74, v74, v74 row_ror:8 row_mask:0xf bank_mask:0xf
    v_sub_f32 v77, v72, v3
    v_sub_f32 v79, v78, v3
    v_add_f32_dpp v74, v74, v74 row_ror:4 row_mask:0xf bank_mask:0xf
    v_mul_f32 v79, v79, v79
    v_sub_f32 v78, v72, v78
    v_add_f32_dpp v74, v74, v74 row_ror:2 row_mask:0xf bank_mask:0xf
    v_fma_f32 v79, -v77, v77, v79
    s_nop 0
    s_nop 0
    v_add_f32_dpp v74, v74, v74 row_ror:1 row_mask:0xf bank_mask:0xf
    v_fmac_f32 v79, s15, v74
    v_cvt_pk_bf16_f32 v79, 0, v79
    v_add_f32 v79, s16, v79
    v_cvt_pk_bf16_f32 v79, 0, v79
    v_sqrt_f32 v79, v79
    v_mul_f32 v81, v78, v4
    v_cvt_pk_bf16_f32 v79, 0, v79
    v_rcp_f32 v79, v79
    s_nop 0
    v_mul_f32_e64 v80, -v79, v4
    v_fma_f32 v76, v79, v81, v5
    v_pk_fma_f32 v[40:41], v[40:41], v[80:81], v[76:77] op_sel_hi:[1,0,0]
    v_pk_fma_f32 v[42:43], v[42:43], v[80:81], v[76:77] op_sel_hi:[1,0,0]
    v_pk_fma_f32 v[44:45], v[44:45], v[80:81], v[76:77] op_sel_hi:[1,0,0]
    v_pk_fma_f32 v[46:47], v[46:47], v[80:81], v[76:77] op_sel_hi:[1,0,0]
    v_cvt_pk_bf16_f32 v24, v40, v41
    v_cvt_pk_bf16_f32 v25, v42, v43
    v_cvt_pk_bf16_f32 v26, v44, v45
    v_cvt_pk_bf16_f32 v27, v46, v47
    global_store_dwordx4 v82, v[24:27], s[10:11] offset:0 nt
    v_pk_fma_f32 v[48:49], v[48:49], v[80:81], v[76:77] op_sel_hi:[1,0,0]
    v_pk_fma_f32 v[50:51], v[50:51], v[80:81], v[76:77] op_sel_hi:[1,0,0]
    v_pk_fma_f32 v[52:53], v[52:53], v[80:81], v[76:77] op_sel_hi:[1,0,0]
    v_pk_fma_f32 v[54:55], v[54:55], v[80:81], v[76:77] op_sel_hi:[1,0,0]
    v_cvt_pk_bf16_f32 v28, v48, v49
    v_cvt_pk_bf16_f32 v29, v50, v51
    v_cvt_pk_bf16_f32 v30, v52, v53
    v_cvt_pk_bf16_f32 v31, v54, v55
    global_store_dwordx4 v82, v[28:31], s[10:11] offset:256 nt
    v_pk_fma_f32 v[56:57], v[56:57], v[80:81], v[76:77] op_sel_hi:[1,0,0]
    v_pk_fma_f32 v[58:59], v[58:59], v[80:81], v[76:77] op_sel_hi:[1,0,0]
    v_pk_fma_f32 v[60:61], v[60:61], v[80:81], v[76:77] op_sel_hi:[1,0,0]
    v_pk_fma_f32 v[62:63], v[62:63], v[80:81], v[76:77] op_sel_hi:[1,0,0]
    v_cvt_pk_bf16_f32 v32, v56, v57
    v_cvt_pk_bf16_f32 v33, v58, v59
    v_cvt_pk_bf16_f32 v34, v60, v61
    v_cvt_pk_bf16_f32 v35, v62, v63
    global_store_dwordx4 v82, v[32:35], s[10:11] offset:512 nt
    v_pk_fma_f32 v[64:65], v[64:65], v[80:81], v[76:77] op_sel_hi:[1,0,0]
    v_pk_fma_f32 v[66:67], v[66:67], v[80:81], v[76:77] op_sel_hi:[1,0,0]
    v_pk_fma_f32 v[68:69], v[68:69], v[80:81], v[76:77] op_sel_hi:[1,0,0]
    v_pk_fma_f32 v[70:71], v[70:71], v[80:81], v[76:77] op_sel_hi:[1,0,0]
    v_cvt_pk_bf16_f32 v36, v64, v65
    v_cvt_pk_bf16_f32 v37, v66, v67
    v_cvt_pk_bf16_f32 v38, v68, v69
    v_cvt_pk_bf16_f32 v39, v70, v71
    global_store_dwordx4 v82, v[36:39], s[10:11] offset:768 nt
L_done:
    s_endpgm
.section .rodata,"a"
.p2align 6
.amdhsa_kernel standalone__instancenorm__sampling_kernel
  .amdhsa_next_free_vgpr 83
  .amdhsa_next_free_sgpr 24
  .amdhsa_accum_offset 84
  .amdhsa_group_segment_fixed_size 0
  .amdhsa_kernarg_size 48
  .amdhsa_user_sgpr_count 2
  .amdhsa_user_sgpr_kernarg_segment_ptr 1
  .amdhsa_system_sgpr_workgroup_id_x 1
  .amdhsa_float_denorm_mode_32 3
.end_amdhsa_kernel
```
